```python
import torch

def _softmax(x, axis=-1):
    return torch.softmax(x, dim=axis)
def _gelu(x):
    return torch.nn.functional.gelu(x, approximate="tanh")
def _silu(x):
    return torch.nn.functional.silu(x)
def _sigmoid(x):
    return torch.sigmoid(x)
def _layernorm(x, axis=-1, eps=1e-5):
    m = x.mean(dim=axis, keepdim=True)
    v = x.var(dim=axis, keepdim=True, unbiased=False)
    return (x - m) / torch.sqrt(v + eps)
def _scatter_add(tgt, idx, src, axis=0):
    return tgt.clone().index_add_(axis, idx, src)
def _segment_sum(src, seg, n):
    out = torch.zeros((n,) + src.shape[1:], dtype=src.dtype)
    return out.index_add_(0, seg, src)
def _pad(x, pw):
    flat = tuple(v for pair in reversed(pw) for v in pair)
    return torch.nn.functional.pad(x, flat)

kernel_name = 'sequential_preLN__sliding_block_cached__glu_gated_reglu__decode'

def setup_inputs():

    _w = (lambda a: (lambda t: t.to(torch.bfloat16) if t.is_floating_point() else t)(torch.as_tensor(a)))
    def _A_setup():
        B, Sq, D = 1, 1, 1024
        Hq, Hkv, Sk, Dh = 32, 4, 65536, 128
        assert Hq % Hkv == 0, (Hq, Hkv)
        return {
            "x": _w((lambda *s: torch.randn(*s, dtype=torch.bfloat16) * 0.05)(B, Sq, D)),
            "k_cache": _w((lambda *s: torch.randn(*s, dtype=torch.bfloat16) * 1.6)(B, Hkv, Sk, Dh)),
            "v_cache": _w((lambda *s: torch.randn(*s, dtype=torch.bfloat16) * 0.8)(B, Hkv, Sk, Dh)),
            "wq": _w((lambda *s: torch.randn(*s, dtype=torch.bfloat16) * 1.6)(D, Hq * Dh) * (D ** -0.5)),
            "wo": _w((lambda *s: torch.randn(*s, dtype=torch.bfloat16) * 0.8)(Hq * Dh, D) * ((Hq * Dh) ** -0.5)),
        }
    _A_in = _A_setup()

    def _B_setup():
        B, S, D, F = 1, 1, 1024, 3584
        return {
            "x": _w((lambda *s: torch.randn(*s, dtype=torch.bfloat16) * 0.05)(B, S, D)),
            "W_gate": _w((lambda *s: torch.randn(*s, dtype=torch.bfloat16) * 0.4)(D, F) * (2.0 / D) ** 0.5),
            "W_up": _w((lambda *s: torch.randn(*s, dtype=torch.bfloat16) * 0.4)(D, F) * (2.0 / D) ** 0.5),
            "W_down": _w((lambda *s: torch.randn(*s, dtype=torch.bfloat16) * 0.4)(F, D) * (1.0 / F) ** 0.5),
        }
    _B_in = _B_setup()

    return {
        "A_x": _A_in["x"],
        "A_k_cache": _A_in["k_cache"],
        "A_v_cache": _A_in["v_cache"],
        "A_wq": _A_in["wq"],
        "A_wo": _A_in["wo"],
        "B_x": _B_in["x"],
        "B_W_gate": _B_in["W_gate"],
        "B_W_up": _B_in["W_up"],
        "B_W_down": _B_in["W_down"],
    }

def reference(A_x, A_k_cache, A_v_cache, A_wq, A_wo, B_x, B_W_gate, B_W_up, B_W_down):
    def _A_ref(x, k_cache, v_cache, wq, wo):
        B, Sq, D = x.shape
        Hq, Dh = 32, 128
        Hkv, Sk = k_cache.shape[1], k_cache.shape[2]
        W = min(4096, max(256, Sk // 4))
        rep = Hq // Hkv
        q = (lambda x, *d: x.permute(*d))((x @ wq).reshape(B, Sq, Hq, Dh), 0, 2, 1, 3)
        k = (lambda x, n, axis: torch.repeat_interleave(x, n, dim=axis))(k_cache[:, :, Sk - W:, :], rep, axis=1)
        v = (lambda x, n, axis: torch.repeat_interleave(x, n, dim=axis))(v_cache[:, :, Sk - W:, :], rep, axis=1)
        scores = torch.einsum("bhqd,bhkd->bhqk", q, k) * (Dh ** -0.5)
        p = _softmax(scores, axis=-1)
        o = torch.einsum("bhqk,bhkd->bhqd", p, v)
        return (lambda x, *d: x.permute(*d))(o, 0, 2, 1, 3).reshape(B, Sq, Hq * Dh) @ wo

    def _B_ref(x, W_gate, W_up, W_down):
        gate = torch.einsum("bsd,df->bsf", x, W_gate)
        up = torch.einsum("bsd,df->bsf", x, W_up)
        gate = gate * (lambda x, dt: x.to(dt))(gate > 0, gate.dtype)
        h = gate * up
        return torch.einsum("bsf,fd->bsd", h, W_down)

    x = A_x
    h = x + _A_ref(_layernorm(x, axis=-1), A_k_cache, A_v_cache, A_wq, A_wo)
    h2 = h + _B_ref(_layernorm(h, axis=-1), B_W_gate, B_W_up, B_W_down)
    return h2
```

```asm
; @launch grid=(256,1,1) block=(256,1,1) lds=98304
.amdgcn_target "amdgcn-amd-amdhsa--gfx950"
.text
.globl sequential_preLN__sliding_block_cached__glu_gated_reglu__decode_kernel
.p2align 8
.type sequential_preLN__sliding_block_cached__glu_gated_reglu__decode_kernel,@function
.set CODE_BYTES, L_CODE_END - L_PCREF
sequential_preLN__sliding_block_cached__glu_gated_reglu__decode_kernel:
  s_cmp_ge_u32 s2, 256
  s_cbranch_scc1 L_END
  s_load_dwordx2 s[8:9], s[0:1], 24
  s_load_dwordx2 s[32:33], s[0:1], 0
  s_load_dwordx2 s[40:41], s[0:1], 88
  s_load_dwordx2 s[12:13], s[0:1], 8
  s_load_dwordx2 s[16:17], s[0:1], 16
  v_lshrrev_b32 v2, 6, v0
  v_and_b32 v1, 63, v0
  s_mov_b32 s10, 0x800000
  v_readfirstlane_b32 s3, v2
  s_getpc_b64 s[84:85]
L_PCREF:
  s_and_b32 s85, s85, 0xffff
  s_mov_b32 s86, CODE_BYTES
  s_mov_b32 s87, 0x20000
  v_lshlrev_b32 v3, 4, v0
  buffer_load_dwordx4 v[88:91], v3, s[84:87], 0 offen
  s_mov_b32 s4, 4096
  buffer_load_dwordx4 v[88:91], v3, s[84:87], s4 offen
  s_mov_b32 s4, 8192
  buffer_load_dwordx4 v[88:91], v3, s[84:87], s4 offen
  s_mov_b32 s11, 0x20000
  s_mov_b32 s34, 2048
  s_mov_b32 s35, 0x20000
  s_and_b32 s4, s2, 0xc0
  s_lshl_b32 s6, s4, 2
  s_lshl_b32 s7, s3, 6
  s_add_u32 s6, s6, s7
  s_lshl_b32 s5, s6, 1
  s_lshl_b32 s6, s6, 13
  s_and_b32 s7, s2, 63
  s_lshl_b32 s7, s7, 7
  s_add_u32 s6, s6, s7
  v_lshrrev_b32 v2, 3, v1
  v_and_b32 v3, 7, v1
  v_lshlrev_b32 v14, 16, v2
  v_lshl_add_u32 v14, v3, 4, v14
  v_lshlrev_b32 v4, 4, v2
  v_lshlrev_b32 v5, 5, v1
  s_waitcnt lgkmcnt(0)
  buffer_load_dwordx4 v[128:131], v14, s[8:11], s6 offen nt
  s_add_u32 s6, s6, 8192
  buffer_load_dwordx4 v[132:135], v14, s[8:11], s6 offen nt
  s_add_u32 s6, s6, 8192
  buffer_load_dwordx4 v[92:95], v5, s[32:35], 0 offen
  buffer_load_dwordx4 v[96:99], v5, s[32:35], 0 offen offset:16
  buffer_load_dwordx4 v[124:127], v4, s[32:35], s5 offen
  buffer_load_dwordx4 v[136:139], v14, s[8:11], s6 offen nt
  s_add_u32 s6, s6, 8192
  buffer_load_dwordx4 v[140:143], v14, s[8:11], s6 offen nt
  s_add_u32 s6, s6, 8192
  buffer_load_dwordx4 v[144:147], v14, s[8:11], s6 offen nt
  s_add_u32 s6, s6, 8192
  buffer_load_dwordx4 v[148:151], v14, s[8:11], s6 offen nt
  s_add_u32 s6, s6, 8192
  buffer_load_dwordx4 v[152:155], v14, s[8:11], s6 offen nt
  s_add_u32 s6, s6, 8192
  buffer_load_dwordx4 v[156:159], v14, s[8:11], s6 offen nt
  s_load_dwordx2 s[20:21], s[0:1], 32
  s_load_dwordx4 s[44:47], s[0:1], 48
  s_load_dwordx2 s[28:29], s[0:1], 64
  s_load_dwordx2 s[36:37], s[0:1], 72
  s_load_dword s54, s[40:41], 0
  s_mov_b32 s14, 0x4000000
  s_mov_b32 s15, 0x20000
  s_mov_b32 s18, 0x4000000
  s_mov_b32 s19, 0x20000
  s_mov_b32 s42, 0x10000000
  s_mov_b32 s43, 0x20000
  s_mov_b32 s22, 0x800000
  s_mov_b32 s23, 0x20000
  s_mov_b32 s38, 2048
  s_mov_b32 s39, 0x20000
  s_mov_b32 s56, 0xff
  s_mov_b32 s60, 0xffff0000
  s_mov_b32 s61, 65536
  s_mov_b32 s92, 0x3db504f3
  s_mov_b32 s93, 0x3db504f3
  s_mov_b32 s90, 0
  s_mov_b32 s91, -1
  v_mov_b32 v8, 0
  v_mov_b32 v9, 0x3f803f80
  s_and_b32 s94, s2, 7
  s_lshr_b32 s95, s2, 3
  s_lshr_b32 s96, s94, 1
  s_lshl_b32 s5, s95, 1
  s_and_b32 s6, s2, 1
  s_add_u32 s97, s5, s6
  s_lshr_b32 s4, s2, 4
  s_lshl_b32 s4, s4, 3
  s_add_u32 s98, s4, s94
  s_and_b32 s99, s95, 1
  s_cmp_lt_u32 s95, 28
  s_cselect_b32 s51, 1, 0
  s_min_u32 s5, s95, 27
  s_mul_i32 s6, s5, 37
  s_lshr_b32 s6, s6, 8
  s_mul_i32 s7, s6, 7
  s_sub_u32 s100, s5, s7
  s_sub_u32 s7, s95, 28
  s_cmp_eq_u32 s51, 0
  s_cselect_b32 s6, s7, s6
  s_lshl_b32 s7, s94, 2
  s_add_u32 s101, s7, s6
  s_mul_i32 s7, s94, 28
  s_add_u32 s55, s7, s5
  v_and_b32 v50, 15, v1
  v_lshrrev_b32 v51, 4, v1
  v_and_b32 v52, 7, v1
  v_lshrrev_b32 v60, 3, v1
  v_lshrrev_b32 v61, 5, v1
  v_lshlrev_b32 v10, 4, v1
  v_lshlrev_b32 v4, 4, v50
  v_lshl_add_u32 v11, v51, 14, v4
  v_lshl_add_u32 v13, v51, 13, v4
  v_mul_u32_u24 v5, 57344, v51
  v_add_u32 v12, v5, v4
  v_xor_b32 v4, v50, v51
  v_lshlrev_b32 v4, 4, v4
  v_lshl_add_u32 v15, v51, 8, v4
  v_lshl_add_u32 v59, v50, 8, v4
  s_lshl_b32 s4, s3, 12
  s_add_u32 s4, s4, 32768
  v_add_u32 v59, s4, v59
  v_lshlrev_b32 v4, 1, v51
  v_xor_b32 v4, v4, v50
  v_lshlrev_b32 v4, 4, v4
  v_lshl_add_u32 v16, v51, 8, v4
  v_xor_b32 v17, 128, v16
  v_lshrrev_b32 v3, 1, v52
  v_and_b32 v4, 1, v52
  v_mov_b32 v180, 0x0c0c0100
  v_mov_b32 v181, 0x01000c0c
  v_mov_b32 v182, 0x0c0c0302
  v_mov_b32 v183, 0x03020c0c
  v_cmp_eq_u32 vcc, 1, v4
  v_mov_b32 v184, 0x0c0c0c0c
  s_nop 0
  v_cndmask_b32 v180, v180, v181, vcc
  v_cndmask_b32 v182, v182, v183, vcc
  v_cmp_eq_u32 vcc, 0, v3
  s_nop 1
  v_cndmask_b32 v64, v184, v180, vcc
  v_cndmask_b32 v65, v184, v182, vcc
  v_cmp_eq_u32 vcc, 1, v3
  s_nop 1
  v_cndmask_b32 v66, v184, v180, vcc
  v_cndmask_b32 v67, v184, v182, vcc
  v_cmp_eq_u32 vcc, 2, v3
  s_nop 1
  v_cndmask_b32 v68, v184, v180, vcc
  v_cndmask_b32 v69, v184, v182, vcc
  v_cmp_eq_u32 vcc, 3, v3
  s_nop 1
  v_cndmask_b32 v70, v184, v180, vcc
  v_cndmask_b32 v71, v184, v182, vcc
  v_and_b32 v3, 1, v60
  v_cmp_eq_u32 vcc, v61, v3
  s_lshl_b32 s4, s3, 1
  v_add_u32 v2, s4, v61
  v_lshlrev_b32 v2, 8, v2
  v_lshl_add_u32 v2, v52, 5, v2
  v_and_b32 v3, 16, v1
  v_add_u32 v2, v2, v3
  v_add_u32 v2, 16384, v2
  v_add_u32 v3, 18432, v10
  v_cndmask_b32 v18, v3, v2, vcc
  v_lshlrev_b32 v3, 9, v51
  v_lshl_add_u32 v19, v50, 4, v3
  s_lshr_b32 s4, s2, 6
  s_lshl_b32 s4, s4, 14
  s_and_b32 s5, s2, 63
  s_lshl_b32 s5, s5, 8
  s_add_u32 s4, s4, s5
  s_add_u32 s4, s4, 65536
  v_add_u32 v20, s4, v10
  s_lshl_b32 s4, s96, 12
  s_add_u32 s4, s4, 65536
  v_lshlrev_b32 v2, 4, v0
  v_add_u32 v21, s4, v2
  v_lshrrev_b32 v2, 5, v0
  v_mul_u32_u24 v2, 272, v2
  v_and_b32 v3, 31, v0
  v_lshl_add_u32 v22, v3, 3, v2
  v_mul_u32_u24 v2, 272, v52
  v_lshl_add_u32 v23, v51, 4, v2
  v_lshlrev_b32 v25, 4, v50
  s_lshl_b32 s4, s3, 2
  v_add_u32 v24, s4, v25
  v_mul_u32_u24 v4, 144, v50
  v_lshl_add_u32 v4, v51, 3, v4
  s_lshl_b32 s4, s3, 5
  v_add_u32 v4, s4, v4
  v_add_u32 v4, 21760, v4
  v_add_u32 v5, 18432, v10
  v_cmp_gt_u32 vcc, 8, v50
  v_mul_u32_u24 v2, 144, v52
  v_lshl_add_u32 v27, v51, 4, v2
  v_cndmask_b32 v26, v5, v4, vcc
  v_lshrrev_b32 v2, 2, v50
  v_lshl_add_u32 v3, v51, 3, v2
  v_lshlrev_b32 v3, 8, v3
  v_and_b32 v4, 3, v50
  v_lshrrev_b32 v5, 1, v4
  s_lshl_b32 s4, s3, 2
  v_add_u32 v5, s4, v5
  v_and_b32 v4, 1, v4
  v_lshl_add_u32 v3, v4, 3, v3
  v_and_b32 v4, 1, v51
  v_lshlrev_b32 v4, 3, v4
  v_lshl_add_u32 v4, v2, 1, v4
  v_xor_b32 v2, v5, v4
  v_lshl_add_u32 v28, v2, 4, v3
  v_add_u32 v5, 2, v5
  v_xor_b32 v2, v5, v4
  v_lshl_add_u32 v29, v2, 4, v3
  s_lshl_b32 s4, s96, 18
  s_lshl_b32 s5, s3, 13
  s_add_u32 s4, s4, s5
  s_lshl_b32 s5, s97, 7
  s_add_u32 s4, s4, s5
  s_add_u32 s4, s4, 262144
  v_lshlrev_b32 v3, 15, v52
  v_lshl_add_u32 v3, v51, 4, v3
  v_and_b32 v4, 8, v1
  v_lshl_add_u32 v3, v4, 3, v3
  v_add_u32 v30, s4, v3
  s_lshl_b32 s5, s96, 13
  s_lshl_b32 s6, s97, 4
  s_add_u32 s5, s5, s6
  s_add_u32 s5, s5, 131072
  v_lshlrev_b32 v5, 10, v50
  v_add_u32 v31, s5, v5
  s_lshl_b32 s4, s98, 13
  s_lshl_b32 s5, s3, 11
  s_add_u32 s4, s4, s5
  s_add_u32 s4, s4, 262144
  v_add_u32 v32, s4, v10
  s_lshr_b32 s5, s98, 2
  s_lshl_b32 s5, s5, 10
  s_add_u32 s5, s5, 131072
  v_add_u32 v33, s5, v10
  s_lshl_b32 s4, s3, 4
  v_add_u32 v2, s4, v60
  v_lshlrev_b32 v34, 2, v2
  v_lshlrev_b32 v2, 2, v52
  v_lshl_add_u32 v2, v61, 1, v2
  v_and_b32 v3, 1, v51
  v_add_u32 v2, v2, v3
  v_lshlrev_b32 v2, 4, v2
  s_lshl_b32 s4, s3, 2
  v_add_u32 v35, s4, v2
  v_and_b32 v2, 31, v1
  v_lshlrev_b32 v36, 4, v2
  v_lshlrev_b32 v4, 2, v50
  v_lshl_add_u32 v4, v61, 1, v4
  v_add_u32 v4, v4, v3
  v_lshlrev_b32 v4, 4, v4
  v_add_u32 v46, s4, v4
  v_lshlrev_b32 v37, 5, v51
  v_lshlrev_b32 v39, 4, v51
  v_and_b32 v3, 8, v1
  v_cmp_ne_u32 vcc, 0, v3
  v_mov_b32 v4, 128
  s_nop 0
  v_cndmask_b32 v38, v37, v4, vcc
  v_lshrrev_b32 v3, 2, v50
  v_lshlrev_b32 v4, 14, v3
  v_and_b32 v5, 3, v50
  v_lshl_add_u32 v4, v5, 5, v4
  v_and_b32 v2, 16, v1
  v_add_u32 v4, v4, v2
  s_lshl_b32 s4, s99, 4
  s_lshl_b32 s5, s3, 2
  s_add_u32 s4, s4, s5
  s_lshl_b32 s4, s4, 14
  s_lshl_b32 s5, s98, 7
  s_add_u32 s4, s4, s5
  s_add_u32 s4, s4, 1310720
  v_add_u32 v40, s4, v4
  v_mul_u32_u24 v4, 28672, v3
  v_lshl_add_u32 v4, v5, 5, v4
  v_add_u32 v4, v4, v2
  s_mul_i32 s4, s3, 229376
  s_lshl_b32 s5, s55, 7
  s_add_u32 s4, s4, s5
  s_add_u32 s4, s4, 4194304
  v_add_u32 v47, s4, v4
  s_lshl_b32 s4, s101, 14
  s_lshl_b32 s5, s3, 12
  s_add_u32 s4, s4, s5
  s_add_u32 s4, s4, 1310720
  v_add_u32 v41, s4, v10
  v_lshrrev_b32 v3, 1, v50
  v_lshlrev_b32 v3, 13, v3
  v_and_b32 v4, 1, v50
  v_lshl_add_u32 v3, v4, 5, v3
  v_add_u32 v3, v3, v2
  v_lshl_add_u32 v3, v61, 6, v3
  s_lshl_b32 s4, s100, 5
  s_and_b32 s5, s3, 1
  s_lshl_b32 s5, s5, 4
  s_add_u32 s4, s4, s5
  s_lshl_b32 s4, s4, 13
  s_lshl_b32 s5, s101, 8
  s_add_u32 s4, s4, s5
  s_lshr_b32 s5, s3, 1
  s_lshl_b32 s5, s5, 7
  s_add_u32 s4, s4, s5
  s_add_u32 s4, s4, 2097152
  v_add_u32 v43, s4, v3
  s_lshl_b32 s4, s55, 13
  s_lshl_b32 s5, s3, 11
  s_add_u32 s4, s4, s5
  s_add_u32 s4, s4, 2097152
  v_add_u32 v44, s4, v10
  v_add_u32 v45, 163840, v36
  s_mul_i32 s4, s101, 28672
  s_mul_i32 s5, s3, 7168
  s_add_u32 s4, s4, s5
  s_add_u32 s4, s4, 4194304
  v_add_u32 v48, s4, v10
  s_lshl_b32 s4, s94, 10
  s_add_u32 s4, s4, 196608
  v_lshlrev_b32 v2, 7, v52
  v_add_u32 v56, s4, v2
  s_lshl_b32 s4, s94, 7
  s_add_u32 s4, s4, 196608
  v_lshlrev_b32 v2, 10, v52
  v_add_u32 v57, s4, v2
  s_lshr_b32 s63, s2, 3
  s_add_u32 s63, s63, s3
  v_and_b32 v2, 31, v1
  v_lshlrev_b32 v2, 1, v2
  s_lshl_b32 s4, s101, 6
  v_add_u32 v49, s4, v2
  buffer_load_ushort v42, v49, s[32:35], 0 offen
  s_waitcnt lgkmcnt(0)
  s_add_u32 s54, s54, 1
  s_and_b32 s59, s54, 0xff
  v_mov_b32 v7, s59
  s_mul_i32 s57, s59, 0x01010101
  s_cmp_ge_u32 s3, 2
  s_cselect_b32 s24, s46, s44
  s_cselect_b32 s25, s47, s45
  s_cmp_eq_u32 s51, 0
  s_cselect_b32 s26, 0, 0x700000
  s_cselect_b32 s30, 0, 0x700000
  s_mov_b32 s27, 0x20000
  s_mov_b32 s31, 0x20000
  s_mov_b32 s44, 16384
  s_mov_b32 s45, 32768
  s_mov_b32 s46, 49152
  s_mov_b32 s47, 65536
  s_mov_b32 s52, 4096
  s_mov_b32 s53, 114688
  s_lshl_b32 s4, s98, 16
  s_lshl_b32 s5, s99, 10
  s_add_u32 s4, s4, s5
  s_lshl_b32 s5, s3, 8
  s_add_u32 s48, s4, s5
  s_mul_i32 s4, s101, 229376
  s_lshl_b32 s5, s100, 10
  s_add_u32 s4, s4, s5
  s_and_b32 s5, s3, 1
  s_lshl_b32 s5, s5, 9
  s_add_u32 s49, s4, s5
  s_lshl_b32 s4, s55, 15
  s_lshl_b32 s5, s3, 9
  s_add_u32 s50, s4, s5
  s_lshl_b32 s6, s96, 24
  s_lshl_b32 s7, s97, 6
  s_lshl_b32 s5, s3, 4
  s_add_u32 s7, s7, s5
  s_add_u32 s7, s7, 61440
  s_lshl_b32 s7, s7, 8
  s_add_u32 s88, s6, s7
  s_lshl_b32 s89, s3, 12
  v_lshlrev_b32 v2, 21, v1
  v_add_u32 v2, 0x1f0000, v2
  s_mov_b64 exec, 7
  buffer_load_dword v89, v2, s[40:43], 0 offen
  s_mov_b64 exec, 1
  buffer_load_dword v89, v8, s[36:39], 0 offen
  s_mov_b64 exec, -1
  s_waitcnt vmcnt(9)
  v_lshlrev_b32 v176, 16, v92
  v_and_b32 v177, s60, v92
  v_lshlrev_b32 v178, 16, v93
  v_and_b32 v179, s60, v93
  v_lshlrev_b32 v180, 16, v94
  v_and_b32 v181, s60, v94
  v_lshlrev_b32 v182, 16, v95
  v_and_b32 v183, s60, v95
  v_lshlrev_b32 v184, 16, v96
  v_and_b32 v185, s60, v96
  v_lshlrev_b32 v186, 16, v97
  v_and_b32 v187, s60, v97
  v_lshlrev_b32 v188, 16, v98
  v_and_b32 v189, s60, v98
  v_lshlrev_b32 v190, 16, v99
  v_and_b32 v191, s60, v99
  v_pk_add_f32 v[92:93], v[176:177], v[178:179]
  v_pk_add_f32 v[94:95], v[180:181], v[182:183]
  v_pk_add_f32 v[96:97], v[184:185], v[186:187]
  v_pk_add_f32 v[98:99], v[188:189], v[190:191]
  v_pk_add_f32 v[92:93], v[92:93], v[94:95]
  v_pk_add_f32 v[96:97], v[96:97], v[98:99]
  v_pk_add_f32 v[92:93], v[92:93], v[96:97]
  v_add_f32 v50, v92, v93
  s_nop 1
  v_add_f32_dpp v50, v50, v50 quad_perm:[1,0,3,2] row_mask:0xf bank_mask:0xf
  s_nop 1
  v_add_f32_dpp v50, v50, v50 quad_perm:[2,3,0,1] row_mask:0xf bank_mask:0xf
  s_nop 1
  v_add_f32_dpp v50, v50, v50 row_half_mirror row_mask:0xf bank_mask:0xf
  s_nop 1
  v_add_f32_dpp v50, v50, v50 row_mirror row_mask:0xf bank_mask:0xf
  v_mov_b32 v2, v50
  s_nop 1
  v_permlane16_swap_b32 v50, v2
  v_add_f32 v50, v50, v2
  v_mov_b32 v2, v50
  s_nop 1
  v_permlane32_swap_b32 v50, v2
  v_add_f32 v50, v50, v2
  v_mul_f32 v50, 0x3a800000, v50
  v_sub_f32 v2, v176, v50
  v_mul_f32 v51, v2, v2
  v_sub_f32 v2, v177, v50
  v_fmac_f32 v51, v2, v2
  v_sub_f32 v2, v178, v50
  v_fmac_f32 v51, v2, v2
  v_sub_f32 v2, v179, v50
  v_fmac_f32 v51, v2, v2
  v_sub_f32 v2, v180, v50
  v_fmac_f32 v51, v2, v2
  v_sub_f32 v2, v181, v50
  v_fmac_f32 v51, v2, v2
  v_sub_f32 v2, v182, v50
  v_fmac_f32 v51, v2, v2
  v_sub_f32 v2, v183, v50
  v_fmac_f32 v51, v2, v2
  v_sub_f32 v2, v184, v50
  v_fmac_f32 v51, v2, v2
  v_sub_f32 v2, v185, v50
  v_fmac_f32 v51, v2, v2
  v_sub_f32 v2, v186, v50
  v_fmac_f32 v51, v2, v2
  v_sub_f32 v2, v187, v50
  v_fmac_f32 v51, v2, v2
  v_sub_f32 v2, v188, v50
  v_fmac_f32 v51, v2, v2
  v_sub_f32 v2, v189, v50
  v_fmac_f32 v51, v2, v2
  v_sub_f32 v2, v190, v50
  v_fmac_f32 v51, v2, v2
  v_sub_f32 v2, v191, v50
  v_fmac_f32 v51, v2, v2
  s_nop 1
  v_add_f32_dpp v51, v51, v51 quad_perm:[1,0,3,2] row_mask:0xf bank_mask:0xf
  s_nop 1
  v_add_f32_dpp v51, v51, v51 quad_perm:[2,3,0,1] row_mask:0xf bank_mask:0xf
  s_nop 1
  v_add_f32_dpp v51, v51, v51 row_half_mirror row_mask:0xf bank_mask:0xf
  s_nop 1
  v_add_f32_dpp v51, v51, v51 row_mirror row_mask:0xf bank_mask:0xf
  v_mov_b32 v2, v51
  s_nop 1
  v_permlane16_swap_b32 v51, v2
  v_add_f32 v51, v51, v2
  v_mov_b32 v2, v51
  s_nop 1
  v_permlane32_swap_b32 v51, v2
  v_add_f32 v51, v51, v2
  s_add_u32 s6, s89, 32768
  s_mov_b32 m0, s6
  s_add_u32 s7, s88, 0
  v_xor_b32 v5, 0, v15
  buffer_load_dwordx4 v5, s[12:15], s7 offen nt lds
  s_add_u32 s6, s89, 33792
  s_mov_b32 m0, s6
  s_add_u32 s7, s88, 1024
  v_xor_b32 v5, 64, v15
  buffer_load_dwordx4 v5, s[12:15], s7 offen nt lds
  v_mul_f32 v51, 0x3a800000, v51
  v_cvt_pk_bf16_f32 v50, v50, v50
  v_and_b32 v50, s60, v50
  v_cvt_pk_bf16_f32 v51, v51, v51
  v_and_b32 v51, s60, v51
  v_add_f32 v51, 0x3727c5ac, v51
  v_cvt_pk_bf16_f32 v51, v51, v51
  v_and_b32 v51, s60, v51
  v_sqrt_f32 v51, v51
  s_nop 0
  v_cvt_pk_bf16_f32 v51, v51, v51
  v_and_b32 v51, s60, v51
  v_rcp_f32 v52, v51
  s_nop 0
  v_lshlrev_b32 v176, 16, v124
  v_and_b32 v177, s60, v124
  v_lshlrev_b32 v178, 16, v125
  v_and_b32 v179, s60, v125
  v_lshlrev_b32 v180, 16, v126
  v_and_b32 v181, s60, v126
  v_lshlrev_b32 v182, 16, v127
  v_and_b32 v183, s60, v127
  v_sub_f32 v176, v176, v50
  v_cvt_pk_bf16_f32 v176, v176, v176
  v_and_b32 v176, s60, v176
  v_mul_f32 v2, v176, v52
  v_fma_f32 v3, -v2, v51, v176
  v_fma_f32 v176, v3, v52, v2
  v_sub_f32 v177, v177, v50
  v_cvt_pk_bf16_f32 v177, v177, v177
  v_and_b32 v177, s60, v177
  v_mul_f32 v2, v177, v52
  v_fma_f32 v3, -v2, v51, v177
  v_fma_f32 v177, v3, v52, v2
  v_sub_f32 v178, v178, v50
  v_cvt_pk_bf16_f32 v178, v178, v178
  v_and_b32 v178, s60, v178
  v_mul_f32 v2, v178, v52
  v_fma_f32 v3, -v2, v51, v178
  v_fma_f32 v178, v3, v52, v2
  v_sub_f32 v179, v179, v50
  v_cvt_pk_bf16_f32 v179, v179, v179
  v_and_b32 v179, s60, v179
  v_mul_f32 v2, v179, v52
  v_fma_f32 v3, -v2, v51, v179
  v_fma_f32 v179, v3, v52, v2
  v_sub_f32 v180, v180, v50
  v_cvt_pk_bf16_f32 v180, v180, v180
  v_and_b32 v180, s60, v180
  v_mul_f32 v2, v180, v52
  v_fma_f32 v3, -v2, v51, v180
  v_fma_f32 v180, v3, v52, v2
  v_sub_f32 v181, v181, v50
  v_cvt_pk_bf16_f32 v181, v181, v181
  v_and_b32 v181, s60, v181
  v_mul_f32 v2, v181, v52
  v_fma_f32 v3, -v2, v51, v181
  v_fma_f32 v181, v3, v52, v2
  v_sub_f32 v182, v182, v50
  v_cvt_pk_bf16_f32 v182, v182, v182
  v_and_b32 v182, s60, v182
  v_mul_f32 v2, v182, v52
  v_fma_f32 v3, -v2, v51, v182
  v_fma_f32 v182, v3, v52, v2
  v_sub_f32 v183, v183, v50
  v_cvt_pk_bf16_f32 v183, v183, v183
  v_and_b32 v183, s60, v183
  v_mul_f32 v2, v183, v52
  v_fma_f32 v3, -v2, v51, v183
  v_fma_f32 v183, v3, v52, v2
  v_cvt_pk_bf16_f32 v124, v176, v177
  v_cvt_pk_bf16_f32 v125, v178, v179
  v_cvt_pk_bf16_f32 v126, v180, v181
  v_cvt_pk_bf16_f32 v127, v182, v183
  s_add_u32 s6, s89, 34816
  s_mov_b32 m0, s6
  s_add_u32 s7, s88, 2048
  v_xor_b32 v5, 128, v15
  buffer_load_dwordx4 v5, s[12:15], s7 offen nt lds
  s_add_u32 s6, s89, 35840
  s_mov_b32 m0, s6
  s_add_u32 s7, s88, 3072
  v_xor_b32 v5, 192, v15
  buffer_load_dwordx4 v5, s[12:15], s7 offen nt lds
  v_perm_b32 v72, v124, v124, v64
  v_perm_b32 v73, v124, v124, v66
  v_perm_b32 v74, v124, v124, v68
  v_perm_b32 v75, v124, v124, v70
  s_waitcnt vmcnt(17)
  v_perm_b32 v76, v124, v124, v65
  v_perm_b32 v77, v124, v124, v67
  v_perm_b32 v78, v124, v124, v69
  v_perm_b32 v79, v124, v124, v71
  v_mfma_f32_16x16x32_bf16 v[80:83], v[72:75], v[128:131], 0
  s_add_u32 s6, s89, 0
  s_mov_b32 m0, s6
  s_add_u32 s7, s88, 0
  buffer_load_dwordx4 v16, s[16:19], s7 offen nt lds
  s_waitcnt vmcnt(17)
  v_perm_b32 v72, v125, v125, v64
  v_perm_b32 v73, v125, v125, v66
  v_perm_b32 v74, v125, v125, v68
  v_perm_b32 v75, v125, v125, v70
  v_mfma_f32_16x16x32_bf16 v[80:83], v[76:79], v[132:135], v[80:83]
  s_waitcnt vmcnt(13)
  v_perm_b32 v76, v125, v125, v65
  v_perm_b32 v77, v125, v125, v67
  v_perm_b32 v78, v125, v125, v69
  v_perm_b32 v79, v125, v125, v71
  v_mfma_f32_16x16x32_bf16 v[80:83], v[72:75], v[136:139], v[80:83]
  s_add_u32 s6, s89, 1024
  s_mov_b32 m0, s6
  s_add_u32 s7, s88, 1024
  buffer_load_dwordx4 v16, s[16:19], s7 offen nt lds
  s_waitcnt vmcnt(13)
  v_perm_b32 v72, v126, v126, v64
  v_perm_b32 v73, v126, v126, v66
  v_perm_b32 v74, v126, v126, v68
  v_perm_b32 v75, v126, v126, v70
  v_mfma_f32_16x16x32_bf16 v[80:83], v[76:79], v[140:143], v[80:83]
  s_waitcnt vmcnt(12)
  v_perm_b32 v76, v126, v126, v65
  v_perm_b32 v77, v126, v126, v67
  v_perm_b32 v78, v126, v126, v69
  v_perm_b32 v79, v126, v126, v71
  v_mfma_f32_16x16x32_bf16 v[80:83], v[72:75], v[144:147], v[80:83]
  s_add_u32 s6, s89, 2048
  s_mov_b32 m0, s6
  s_add_u32 s7, s88, 2048
  buffer_load_dwordx4 v17, s[16:19], s7 offen nt lds
  s_waitcnt vmcnt(12)
  v_perm_b32 v72, v127, v127, v64
  v_perm_b32 v73, v127, v127, v66
  v_perm_b32 v74, v127, v127, v68
  v_perm_b32 v75, v127, v127, v70
  v_mfma_f32_16x16x32_bf16 v[80:83], v[76:79], v[148:151], v[80:83]
  s_waitcnt vmcnt(11)
  v_perm_b32 v76, v127, v127, v65
  v_perm_b32 v77, v127, v127, v67
  v_perm_b32 v78, v127, v127, v69
  v_perm_b32 v79, v127, v127, v71
  v_mfma_f32_16x16x32_bf16 v[80:83], v[72:75], v[152:155], v[80:83]
  s_add_u32 s6, s89, 3072
  s_mov_b32 m0, s6
  s_add_u32 s7, s88, 3072
  buffer_load_dwordx4 v17, s[16:19], s7 offen nt lds
  s_waitcnt vmcnt(11)
  s_nop 0
  v_mfma_f32_16x16x32_bf16 v[80:83], v[76:79], v[156:159], v[80:83]
  s_nop 7
  ds_write_b128 v18, v[80:83]
  s_waitcnt lgkmcnt(0)
  s_barrier
  s_cmp_lg_u32 s3, 0
  s_cbranch_scc1 L_p1skip_1
  ds_read_b128 v[92:95], v19 offset:16384
  ds_read_b128 v[96:99], v19 offset:16640
  s_waitcnt lgkmcnt(0)
  v_pk_add_f32 v[92:93], v[92:93], v[96:97]
  v_pk_add_f32 v[94:95], v[94:95], v[98:99]
  v_mov_b32 v176, v92
  v_mov_b32 v177, v93
  v_mov_b32 v178, v94
  v_mov_b32 v179, v95
  v_permlane16_swap_b32 v92, v176
  v_permlane16_swap_b32 v93, v177
  v_permlane16_swap_b32 v94, v178
  v_permlane16_swap_b32 v95, v179
  v_add_f32 v92, v92, v176
  v_add_f32 v93, v93, v177
  v_add_f32 v94, v94, v178
  v_add_f32 v95, v95, v179
  v_mov_b32 v176, v92
  v_mov_b32 v177, v93
  v_mov_b32 v178, v94
  v_mov_b32 v179, v95
  v_permlane32_swap_b32 v92, v176
  v_permlane32_swap_b32 v93, v177
  v_permlane32_swap_b32 v94, v178
  v_permlane32_swap_b32 v95, v179
  v_add_f32 v92, v92, v176
  v_add_f32 v93, v93, v177
  v_add_f32 v94, v94, v178
  v_add_f32 v95, v95, v179
  v_add_u32 v92, 0x80, v92
  v_add_u32 v93, 0x80, v93
  v_add_u32 v94, 0x80, v94
  v_add_u32 v95, 0x80, v95
  v_bfi_b32 v92, s56, v7, v92
  v_bfi_b32 v93, s56, v7, v93
  v_bfi_b32 v94, s56, v7, v94
  v_bfi_b32 v95, s56, v7, v95
  s_mov_b64 exec, 0xffff
  buffer_store_dwordx4 v[92:95], v20, s[40:43], 0 offen sc1
  s_mov_b64 exec, -1
L_p1skip_1:
  s_sleep 6
  buffer_load_dwordx4 a[64:67], v11, s[20:23], s48 offen nt
  s_add_u32 s48, s48, 2048
  s_sleep 6
  buffer_load_dwordx4 a[68:71], v11, s[20:23], s48 offen nt
  s_add_u32 s48, s48, 2048
  s_sleep 6
  buffer_load_dwordx4 a[72:75], v11, s[20:23], s48 offen nt
  s_add_u32 s48, s48, 2048
  s_sleep 6
  buffer_load_dwordx4 a[76:79], v11, s[20:23], s48 offen nt
  s_add_u32 s48, s48, 2048
  s_sleep 6
  buffer_load_dwordx4 a[80:83], v11, s[20:23], s48 offen nt
  s_add_u32 s48, s48, 2048
  s_sleep 6
  buffer_load_dwordx4 a[84:87], v11, s[20:23], s48 offen nt
  s_add_u32 s48, s48, 2048
  s_sleep 12
  buffer_load_dwordx4 v[92:95], v21, s[40:43], 0 offen sc1
  buffer_load_dwordx4 v[96:99], v21, s[40:43], s44 offen sc1
  buffer_load_dwordx4 v[100:103], v21, s[40:43], s45 offen sc1
  buffer_load_dwordx4 v[104:107], v21, s[40:43], s46 offen sc1
  s_sleep 4
  buffer_load_dwordx4 a[88:91], v11, s[20:23], s48 offen nt
  s_add_u32 s48, s48, 2048
  s_sleep 4
  buffer_load_dwordx4 a[92:95], v11, s[20:23], s48 offen nt
  s_add_u32 s48, s48, 2048
  s_sleep 4
  buffer_load_dwordx4 a[0:3], v12, s[24:27], s49 offen offset:0 nt
  s_sleep 4
  buffer_load_dwordx4 a[4:7], v12, s[24:27], s49 offen offset:256 nt
  s_add_u32 s49, s49, 7168
  s_sleep 4
  buffer_load_dwordx4 a[8:11], v12, s[24:27], s49 offen offset:0 nt
  s_sleep 4
  buffer_load_dwordx4 a[12:15], v12, s[24:27], s49 offen offset:256 nt
  s_add_u32 s49, s49, 7168
  s_waitcnt vmcnt(6)
  v_xor_b32 v92, s59, v92
  v_xor_b32 v93, s59, v93
  v_xor_b32 v94, s59, v94
  v_xor_b32 v95, s59, v95
  v_xor_b32 v96, s59, v96
  v_xor_b32 v97, s59, v97
  v_xor_b32 v98, s59, v98
  v_xor_b32 v99, s59, v99
  v_xor_b32 v100, s59, v100
  v_xor_b32 v101, s59, v101
  v_xor_b32 v102, s59, v102
  v_xor_b32 v103, s59, v103
  v_xor_b32 v104, s59, v104
  v_xor_b32 v105, s59, v105
  v_xor_b32 v106, s59, v106
  v_xor_b32 v107, s59, v107
  v_or3_b32 v6, v92, v93, v94
  v_or3_b32 v6, v95, v96, v6
  v_or3_b32 v6, v97, v98, v6
  v_or3_b32 v6, v99, v100, v6
  v_or3_b32 v6, v101, v102, v6
  v_or3_b32 v6, v103, v104, v6
  v_or3_b32 v6, v105, v106, v6
  v_or_b32 v6, v6, v107
  v_cmp_ne_u32_sdwa vcc, v6, v8 src0_sel:BYTE_0 src1_sel:DWORD
  s_cbranch_vccz L_ok_2
L_retry_3:
  s_sub_u32 s61, s61, 1
  s_cbranch_scc1 L_END
  s_sleep 3
  buffer_load_dwordx4 v[92:95], v21, s[40:43], 0 offen sc1
  buffer_load_dwordx4 v[96:99], v21, s[40:43], s44 offen sc1
  buffer_load_dwordx4 v[100:103], v21, s[40:43], s45 offen sc1
  buffer_load_dwordx4 v[104:107], v21, s[40:43], s46 offen sc1
  s_waitcnt vmcnt(0)
  v_xor_b32 v92, s59, v92
  v_xor_b32 v93, s59, v93
  v_xor_b32 v94, s59, v94
  v_xor_b32 v95, s59, v95
  v_xor_b32 v96, s59, v96
  v_xor_b32 v97, s59, v97
  v_xor_b32 v98, s59, v98
  v_xor_b32 v99, s59, v99
  v_xor_b32 v100, s59, v100
  v_xor_b32 v101, s59, v101
  v_xor_b32 v102, s59, v102
  v_xor_b32 v103, s59, v103
  v_xor_b32 v104, s59, v104
  v_xor_b32 v105, s59, v105
  v_xor_b32 v106, s59, v106
  v_xor_b32 v107, s59, v107
  v_or3_b32 v6, v92, v93, v94
  v_or3_b32 v6, v95, v96, v6
  v_or3_b32 v6, v97, v98, v6
  v_or3_b32 v6, v99, v100, v6
  v_or3_b32 v6, v101, v102, v6
  v_or3_b32 v6, v103, v104, v6
  v_or3_b32 v6, v105, v106, v6
  v_or_b32 v6, v6, v107
  v_cmp_ne_u32_sdwa vcc, v6, v8 src0_sel:BYTE_0 src1_sel:DWORD
  s_cbranch_vccnz L_retry_3
  s_branch L_ok_2
L_ok_2:
  v_pk_add_f32 v[92:93], v[92:93], v[96:97]
  v_pk_add_f32 v[94:95], v[94:95], v[98:99]
  v_pk_add_f32 v[100:101], v[100:101], v[104:105]
  v_pk_add_f32 v[102:103], v[102:103], v[106:107]
  v_pk_add_f32 v[92:93], v[92:93], v[100:101]
  v_pk_add_f32 v[94:95], v[94:95], v[102:103]
  v_cvt_pk_bf16_f32 v92, v92, v93
  v_cvt_pk_bf16_f32 v93, v94, v95
  ds_write_b64 v22, v[92:93] offset:19456
  s_waitcnt lgkmcnt(0)
  s_barrier
  buffer_load_dwordx4 a[16:19], v12, s[24:27], s49 offen offset:0 nt
  ds_read_b128 v[92:95], v23 offset:19456
  ds_read_b128 v[96:99], v23 offset:19520
  ds_read_b128 v[100:103], v23 offset:19584
  ds_read_b128 v[104:107], v23 offset:19648
  s_waitcnt vmcnt(21)
  v_xor_b32 v5, 0, v59
  ds_read_b128 v[160:163], v5
  v_xor_b32 v5, 64, v59
  ds_read_b128 v[164:167], v5
  v_xor_b32 v5, 128, v59
  ds_read_b128 v[168:171], v5
  v_xor_b32 v5, 192, v59
  ds_read_b128 v[172:175], v5
  s_waitcnt lgkmcnt(0)
  v_mfma_f32_16x16x32_bf16 v[80:83], v[160:163], v[92:95], 0
  v_mfma_f32_16x16x32_bf16 v[80:83], v[164:167], v[96:99], v[80:83]
  v_mfma_f32_16x16x32_bf16 v[80:83], v[168:171], v[100:103], v[80:83]
  v_mfma_f32_16x16x32_bf16 v[80:83], v[172:175], v[104:107], v[80:83]
  s_nop 7
  v_cvt_pk_bf16_f32 v2, v80, v81
  v_cvt_pk_bf16_f32 v3, v82, v83
  v_lshlrev_b32 v80, 16, v2
  v_and_b32 v81, s60, v2
  v_lshlrev_b32 v82, 16, v3
  v_and_b32 v83, s60, v3
  v_pk_mul_f32 v[80:81], v[80:81], s[92:93]
  v_pk_mul_f32 v[82:83], v[82:83], s[92:93]
  v_cvt_pk_bf16_f32 v2, v80, v81
  v_cvt_pk_bf16_f32 v3, v82, v83
  v_lshlrev_b32 v80, 16, v2
  v_and_b32 v81, s60, v2
  v_lshlrev_b32 v82, 16, v3
  v_and_b32 v83, s60, v3
  v_max_f32 v50, v80, v81
  v_max3_f32 v50, v82, v83, v50
  buffer_load_dwordx4 a[20:23], v12, s[24:27], s49 offen offset:256 nt
  s_add_u32 s49, s49, 7168
  v_mov_b32 v2, v50
  s_nop 1
  v_permlane16_swap_b32 v50, v2
  v_max_f32 v50, v50, v2
  v_mov_b32 v2, v50
  s_nop 1
  v_permlane32_swap_b32 v50, v2
  v_max_f32 v50, v50, v2
  ds_write_b32 v24, v50 offset:23040
  buffer_load_dwordx4 a[24:27], v12, s[24:27], s49 offen offset:0 nt
  buffer_load_dwordx4 a[28:31], v12, s[24:27], s49 offen offset:256 nt
  s_add_u32 s49, s49, 7168
  s_waitcnt lgkmcnt(0)
  s_barrier
  ds_read_b128 v[92:95], v25 offset:23040
  s_waitcnt lgkmcnt(0)
  v_max_f32 v50, v92, v93
  v_max3_f32 v50, v94, v95, v50
  v_mul_f32 v51, 0x3fb8aa3b, v50
  v_mov_b32 v2, 0x3fb8aa3b
  v_fma_f32 v80, v80, v2, -v51
  v_fma_f32 v81, v81, v2, -v51
  v_fma_f32 v82, v82, v2, -v51
  v_fma_f32 v83, v83, v2, -v51
  v_exp_f32 v80, v80
  v_exp_f32 v81, v81
  v_exp_f32 v82, v82
  v_exp_f32 v83, v83
  s_nop 0
  v_cvt_pk_bf16_f32 v92, v80, v81
  v_cvt_pk_bf16_f32 v93, v82, v83
  ds_write_b64 v26, v[92:93]
  buffer_load_dwordx4 a[32:35], v12, s[24:27], s49 offen offset:0 nt
  v_mov_b32 v72, v9
  v_mov_b32 v73, v9
  v_mov_b32 v74, v9
  v_mov_b32 v75, v9
  s_waitcnt vmcnt(21) lgkmcnt(0)
  s_barrier
  ds_read_b128 v[92:95], v27 offset:21760
  ds_read_b128 v[96:99], v27 offset:21824
  ds_read_b64_tr_b16 v[176:177], v28 offset:0
  ds_read_b64_tr_b16 v[178:179], v28 offset:1024
  ds_read_b64_tr_b16 v[180:181], v28 offset:8192
  ds_read_b64_tr_b16 v[182:183], v28 offset:9216
  ds_read_b64_tr_b16 v[184:185], v29 offset:0
  ds_read_b64_tr_b16 v[186:187], v29 offset:1024
  ds_read_b64_tr_b16 v[188:189], v29 offset:8192
  ds_read_b64_tr_b16 v[190:191], v29 offset:9216
  s_waitcnt lgkmcnt(0)
  v_mfma_f32_16x16x32_bf16 v[88:91], v[72:75], v[92:95], 0
  v_mfma_f32_16x16x32_bf16 v[80:83], v[176:179], v[92:95], 0
  v_mfma_f32_16x16x32_bf16 v[84:87], v[184:187], v[92:95], 0
  v_mfma_f32_16x16x32_bf16 v[88:91], v[72:75], v[96:99], v[88:91]
  v_mfma_f32_16x16x32_bf16 v[80:83], v[180:183], v[96:99], v[80:83]
  v_mfma_f32_16x16x32_bf16 v[84:87], v[188:191], v[96:99], v[84:87]
  buffer_load_dwordx4 a[36:39], v12, s[24:27], s49 offen offset:256 nt
  s_add_u32 s49, s49, 7168
  v_mov_b32 v120, v50
  v_mov_b32 v122, v50
  s_nop 4
  v_mov_b32 v121, v88
  v_mov_b32 v123, v88
  v_mov_b32_dpp v80, v84 row_shr:8 row_mask:0xf bank_mask:0xc
  v_mov_b32_dpp v81, v85 row_shr:8 row_mask:0xf bank_mask:0xc
  v_mov_b32_dpp v82, v86 row_shr:8 row_mask:0xf bank_mask:0xc
  v_mov_b32_dpp v83, v87 row_shr:8 row_mask:0xf bank_mask:0xc
  v_bfi_b32 v80, s56, v7, v80
  v_bfi_b32 v81, s56, v7, v81
  v_bfi_b32 v82, s56, v7, v82
  v_bfi_b32 v83, s56, v7, v83
  buffer_store_dwordx4 v[80:83], v30, s[40:43], 0 offen sc1
  s_mov_b64 exec, 0xff
  s_cmp_lg_u32 s3, 0
  s_cbranch_scc1 L_mlskip_4
  v_bfi_b32 v120, s56, v7, v120
  v_bfi_b32 v121, s56, v7, v121
  v_bfi_b32 v122, s56, v7, v122
  v_bfi_b32 v123, s56, v7, v123
  buffer_store_dwordx4 v[120:123], v31, s[40:43], 0 offen sc1
L_mlskip_4:
  s_mov_b64 exec, -1
  s_sleep 5
  buffer_load_dwordx4 a[40:43], v12, s[24:27], s49 offen offset:0 nt
  s_sleep 5
  buffer_load_dwordx4 a[44:47], v12, s[24:27], s49 offen offset:256 nt
  s_add_u32 s49, s49, 7168
  s_sleep 5
  buffer_load_dwordx4 a[48:51], v12, s[24:27], s49 offen offset:0 nt
  s_sleep 5
  buffer_load_dwordx4 a[52:55], v12, s[24:27], s49 offen offset:256 nt
  s_add_u32 s49, s49, 7168
  s_sleep 5
  buffer_load_dwordx4 a[56:59], v12, s[24:27], s49 offen offset:0 nt
  s_sleep 5
  buffer_load_dwordx4 a[60:63], v12, s[24:27], s49 offen offset:256 nt
  s_add_u32 s49, s49, 7168
  s_sleep 5
  buffer_load_dwordx4 v[128:131], v13, s[28:31], s50 offen offset:0 nt
  s_sleep 14
  buffer_load_dwordx4 v[120:123], v33, s[40:43], 0 offen sc1
  buffer_load_dwordx4 v[92:95], v32, s[40:43], 0 offen sc1
  buffer_load_dwordx4 v[96:99], v32, s[40:43], 0 offen offset:1024 sc1
  s_sleep 4
  buffer_load_dwordx4 v[132:135], v13, s[28:31], s50 offen offset:256 nt
  s_add_u32 s50, s50, 2048
  s_sleep 4
  buffer_load_dwordx4 v[136:139], v13, s[28:31], s50 offen offset:0 nt
  s_sleep 4
  buffer_load_dwordx4 v[140:143], v13, s[28:31], s50 offen offset:256 nt
  s_add_u32 s50, s50, 2048
  s_sleep 4
  buffer_load_dwordx4 v[144:147], v13, s[28:31], s50 offen offset:0 nt
  s_sleep 4
  buffer_load_dwordx4 v[148:151], v13, s[28:31], s50 offen offset:256 nt
  s_add_u32 s50, s50, 2048
  s_waitcnt vmcnt(5)
  v_bitop3_b32 v6, v120, v121, s57 bitop3:0x7e
  v_bitop3_b32 v3, v122, v123, s57 bitop3:0x7e
  v_or_b32 v6, v6, v3
  v_bitop3_b32 v2, v92, v93, s57 bitop3:0x7e
  v_bitop3_b32 v3, v94, v95, s57 bitop3:0x7e
  v_or3_b32 v6, v2, v3, v6
  v_bitop3_b32 v2, v96, v97, s57 bitop3:0x7e
  v_bitop3_b32 v3, v98, v99, s57 bitop3:0x7e
  v_or3_b32 v6, v2, v3, v6
  v_cmp_ne_u32_sdwa vcc, v6, v8 src0_sel:BYTE_0 src1_sel:DWORD
  s_cbranch_vccz L_ok_5
L_retry_6:
  s_sub_u32 s61, s61, 1
  s_cbranch_scc1 L_END
  s_sleep 3
  buffer_load_dwordx4 v[120:123], v33, s[40:43], 0 offen sc1
  buffer_load_dwordx4 v[92:95], v32, s[40:43], 0 offen sc1
  buffer_load_dwordx4 v[96:99], v32, s[40:43], 0 offen offset:1024 sc1
  s_waitcnt vmcnt(0)
  v_bitop3_b32 v6, v120, v121, s57 bitop3:0x7e
  v_bitop3_b32 v3, v122, v123, s57 bitop3:0x7e
  v_or_b32 v6, v6, v3
  v_bitop3_b32 v2, v92, v93, s57 bitop3:0x7e
  v_bitop3_b32 v3, v94, v95, s57 bitop3:0x7e
  v_or3_b32 v6, v2, v3, v6
  v_bitop3_b32 v2, v96, v97, s57 bitop3:0x7e
  v_bitop3_b32 v3, v98, v99, s57 bitop3:0x7e
  v_or3_b32 v6, v2, v3, v6
  v_cmp_ne_u32_sdwa vcc, v6, v8 src0_sel:BYTE_0 src1_sel:DWORD
  s_cbranch_vccnz L_retry_6
  s_branch L_ok_5
L_ok_5:
  buffer_load_dwordx4 v[152:155], v13, s[28:31], s50 offen offset:0 nt
  buffer_load_dwordx4 v[156:159], v13, s[28:31], s50 offen offset:256 nt
  s_add_u32 s50, s50, 2048
  v_and_b32 v120, s60, v120
  ds_bpermute_b32 v60, v34, v120
  ds_bpermute_b32 v61, v34, v120 offset:32
  v_mov_b32 v50, v120
  s_nop 1
  v_max_f32_dpp v50, v50, v50 quad_perm:[1,0,3,2] row_mask:0xf bank_mask:0xf
  s_nop 1
  v_max_f32_dpp v50, v50, v50 quad_perm:[2,3,0,1] row_mask:0xf bank_mask:0xf
  s_nop 1
  v_max_f32_dpp v50, v50, v50 row_half_mirror row_mask:0xf bank_mask:0xf
  s_nop 1
  v_max_f32_dpp v50, v50, v50 row_mirror row_mask:0xf bank_mask:0xf
  v_mov_b32 v2, v50
  s_nop 1
  v_permlane16_swap_b32 v50, v2
  v_max_f32 v50, v50, v2
  v_mov_b32 v2, v50
  s_nop 1
  v_permlane32_swap_b32 v50, v2
  v_max_f32 v50, v50, v2
  v_mov_b32 v4, 0x3fb8aa3b
  v_mul_f32 v50, v50, v4
  s_waitcnt lgkmcnt(0)
  v_fma_f32 v51, v120, v4, -v50
  v_fma_f32 v60, v60, v4, -v50
  v_fma_f32 v61, v61, v4, -v50
  v_exp_f32 v51, v51
  v_exp_f32 v60, v60
  v_exp_f32 v61, v61
  v_mul_f32 v52, v51, v121
  v_pk_mul_f32 v[92:93], v[92:93], v[60:61] op_sel_hi:[1,0]
  v_pk_mul_f32 v[94:95], v[94:95], v[60:61] op_sel_hi:[1,0]
  v_pk_fma_f32 v[92:93], v[96:97], v[60:61], v[92:93] op_sel:[0,1,0] op_sel_hi:[1,1,1]
  v_pk_fma_f32 v[94:95], v[98:99], v[60:61], v[94:95] op_sel:[0,1,0] op_sel_hi:[1,1,1]
  v_add_f32_dpp v52, v52, v52 quad_perm:[1,0,3,2] row_mask:0xf bank_mask:0xf
  s_nop 0
  v_permlane32_swap_b32 v92, v94
  v_permlane32_swap_b32 v93, v95
  v_add_f32_dpp v52, v52, v52 quad_perm:[2,3,0,1] row_mask:0xf bank_mask:0xf
  v_add_f32 v92, v92, v94
  v_add_f32 v93, v93, v95
  v_add_f32_dpp v52, v52, v52 row_half_mirror row_mask:0xf bank_mask:0xf
  s_nop 0
  v_permlane16_swap_b32 v92, v93
  v_add_f32 v92, v92, v93
  v_add_f32_dpp v52, v52, v52 row_mirror row_mask:0xf bank_mask:0xf
  s_nop 0
  v_add_f32_dpp v92, v92, v92 row_ror:8 row_mask:0xf bank_mask:0xf
  ds_write_b32 v35, v92 offset:16384
  v_mov_b32 v2, v52
  s_nop 1
  v_permlane16_swap_b32 v52, v2
  v_add_f32 v52, v52, v2
  v_mov_b32 v2, v52
  s_nop 1
  v_permlane32_swap_b32 v52, v2
  v_add_f32 v52, v52, v2
  v_rcp_f32 v52, v52
  s_waitcnt lgkmcnt(0)
  s_barrier
  ds_read_b128 v[92:95], v36 offset:16384
  s_waitcnt lgkmcnt(0)
  v_pk_add_f32 v[92:93], v[92:93], v[94:95]
  v_add_f32 v92, v92, v93
  v_mul_f32 v50, v92, v52
  s_cmp_lg_u32 s63, 0
  s_cbranch_scc1 L_sp_7
  s_mov_b64 s[6:7], exec
  s_mov_b64 exec, 0xff
  v_mov_b32 v2, s54
  s_mov_b32 s4, 16384
  buffer_store_dword v2, v56, s[40:43], s4 offen sc1
  s_mov_b64 exec, s[6:7]
L_sp_7:
  s_nop 1
  v_mov_b32_dpp v2, v50 quad_perm:[1,1,3,3] row_mask:0xf bank_mask:0xf
  v_cvt_pk_bf16_f32 v2, v50, v2
  ds_bpermute_b32 v124, v37, v2 offset:0
  ds_bpermute_b32 v125, v37, v2 offset:8
  ds_bpermute_b32 v126, v37, v2 offset:16
  ds_bpermute_b32 v127, v37, v2 offset:24
  s_waitcnt lgkmcnt(0)
  v_perm_b32 v72, v124, v124, v64
  v_perm_b32 v73, v124, v124, v66
  v_perm_b32 v74, v124, v124, v68
  v_perm_b32 v75, v124, v124, v70
  s_waitcnt vmcnt(28)
  v_perm_b32 v76, v124, v124, v65
  v_perm_b32 v77, v124, v124, v67
  v_perm_b32 v78, v124, v124, v69
  v_perm_b32 v79, v124, v124, v71
  v_mfma_f32_16x16x32_bf16 v[80:83], v[72:75], a[64:67], 0
  v_perm_b32 v72, v125, v125, v64
  v_perm_b32 v73, v125, v125, v66
  v_perm_b32 v74, v125, v125, v68
  v_perm_b32 v75, v125, v125, v70
  v_mfma_f32_16x16x32_bf16 v[80:83], v[76:79], a[68:71], v[80:83]
  v_perm_b32 v76, v125, v125, v65
  v_perm_b32 v77, v125, v125, v67
  v_perm_b32 v78, v125, v125, v69
  v_perm_b32 v79, v125, v125, v71
  v_mfma_f32_16x16x32_bf16 v[80:83], v[72:75], a[72:75], v[80:83]
  v_perm_b32 v72, v126, v126, v64
  v_perm_b32 v73, v126, v126, v66
  v_perm_b32 v74, v126, v126, v68
  v_perm_b32 v75, v126, v126, v70
  v_mfma_f32_16x16x32_bf16 v[80:83], v[76:79], a[76:79], v[80:83]
  v_perm_b32 v76, v126, v126, v65
  v_perm_b32 v77, v126, v126, v67
  v_perm_b32 v78, v126, v126, v69
  v_perm_b32 v79, v126, v126, v71
  v_mfma_f32_16x16x32_bf16 v[80:83], v[72:75], a[80:83], v[80:83]
  v_perm_b32 v72, v127, v127, v64
  v_perm_b32 v73, v127, v127, v66
  v_perm_b32 v74, v127, v127, v68
  v_perm_b32 v75, v127, v127, v70
  v_mfma_f32_16x16x32_bf16 v[80:83], v[76:79], a[84:87], v[80:83]
  v_perm_b32 v76, v127, v127, v65
  v_perm_b32 v77, v127, v127, v67
  v_perm_b32 v78, v127, v127, v69
  v_perm_b32 v79, v127, v127, v71
  v_mfma_f32_16x16x32_bf16 v[80:83], v[72:75], a[88:91], v[80:83]
  s_nop 0
  v_mfma_f32_16x16x32_bf16 v[80:83], v[76:79], a[92:95], v[80:83]
  s_nop 7
  v_bfi_b32 v80, s56, v7, v80
  v_bfi_b32 v81, s56, v7, v81
  v_bfi_b32 v82, s56, v7, v82
  v_bfi_b32 v83, s56, v7, v83
  s_mov_b32 exec_hi, 0
  buffer_store_dwordx4 v[80:83], v40, s[40:43], 0 offen sc1
  s_mov_b64 exec, -1
  s_cmp_lg_u32 s3, 0
  s_cbranch_scc1 L_sw_8_ok
  s_mov_b32 s4, 16384
L_sw_8:
  buffer_load_dword v2, v57, s[40:43], s4 offen sc1
  s_waitcnt vmcnt(0)
  v_cmp_ne_u32 vcc, s54, v2
  s_cbranch_vccz L_sw_8_ok
  s_sub_u32 s61, s61, 1
  s_cbranch_scc1 L_END
  s_sleep 1
  s_branch L_sw_8
L_sw_8_ok:
  s_barrier
  buffer_load_dwordx4 v[92:95], v41, s[40:43], 0 offen offset:0 sc1
  buffer_load_dwordx4 v[96:99], v41, s[40:43], 0 offen offset:1024 sc1
  buffer_load_dwordx4 v[100:103], v41, s[40:43], 0 offen offset:2048 sc1
  buffer_load_dwordx4 v[104:107], v41, s[40:43], 0 offen offset:3072 sc1
  s_waitcnt vmcnt(0)
  v_bitop3_b32 v6, v92, v93, s57 bitop3:0x7e
  v_bitop3_b32 v3, v94, v95, s57 bitop3:0x7e
  v_or_b32 v6, v6, v3
  v_bitop3_b32 v2, v96, v97, s57 bitop3:0x7e
  v_bitop3_b32 v3, v98, v99, s57 bitop3:0x7e
  v_or3_b32 v6, v2, v3, v6
  v_bitop3_b32 v2, v100, v101, s57 bitop3:0x7e
  v_bitop3_b32 v3, v102, v103, s57 bitop3:0x7e
  v_or3_b32 v6, v2, v3, v6
  v_bitop3_b32 v2, v104, v105, s57 bitop3:0x7e
  v_bitop3_b32 v3, v106, v107, s57 bitop3:0x7e
  v_or3_b32 v6, v2, v3, v6
  v_cmp_ne_u32_sdwa vcc, v6, v8 src0_sel:BYTE_0 src1_sel:DWORD
  s_cbranch_vccz L_ok_9
L_retry_10:
  s_sub_u32 s61, s61, 1
  s_cbranch_scc1 L_END
  s_sleep 3
  buffer_load_dwordx4 v[92:95], v41, s[40:43], 0 offen offset:0 sc1
  buffer_load_dwordx4 v[96:99], v41, s[40:43], 0 offen offset:1024 sc1
  buffer_load_dwordx4 v[100:103], v41, s[40:43], 0 offen offset:2048 sc1
  buffer_load_dwordx4 v[104:107], v41, s[40:43], 0 offen offset:3072 sc1
  s_waitcnt vmcnt(0)
  v_bitop3_b32 v6, v92, v93, s57 bitop3:0x7e
  v_bitop3_b32 v3, v94, v95, s57 bitop3:0x7e
  v_or_b32 v6, v6, v3
  v_bitop3_b32 v2, v96, v97, s57 bitop3:0x7e
  v_bitop3_b32 v3, v98, v99, s57 bitop3:0x7e
  v_or3_b32 v6, v2, v3, v6
  v_bitop3_b32 v2, v100, v101, s57 bitop3:0x7e
  v_bitop3_b32 v3, v102, v103, s57 bitop3:0x7e
  v_or3_b32 v6, v2, v3, v6
  v_bitop3_b32 v2, v104, v105, s57 bitop3:0x7e
  v_bitop3_b32 v3, v106, v107, s57 bitop3:0x7e
  v_or3_b32 v6, v2, v3, v6
  v_cmp_ne_u32_sdwa vcc, v6, v8 src0_sel:BYTE_0 src1_sel:DWORD
  s_cbranch_vccnz L_retry_10
  s_branch L_ok_9
L_ok_9:
  v_pk_add_f32 v[92:93], v[92:93], v[96:97]
  v_pk_add_f32 v[94:95], v[94:95], v[98:99]
  v_pk_add_f32 v[100:101], v[100:101], v[104:105]
  v_pk_add_f32 v[102:103], v[102:103], v[106:107]
  v_pk_add_f32 v[92:93], v[92:93], v[100:101]
  v_pk_add_f32 v[94:95], v[94:95], v[102:103]
  s_nop 1
  v_permlane32_swap_b32 v92, v94
  v_permlane32_swap_b32 v93, v95
  v_add_f32 v92, v92, v94
  v_add_f32 v93, v93, v95
  s_nop 1
  v_permlane16_swap_b32 v92, v93
  v_add_f32 v92, v92, v93
  s_nop 1
  v_add_f32_dpp v92, v92, v92 row_ror:8 row_mask:0xf bank_mask:0xf
  ds_write_b32 v35, v92 offset:23552
  v_lshlrev_b32 v42, 16, v42
  s_waitcnt lgkmcnt(0)
  s_barrier
  ds_read_b128 v[92:95], v36 offset:23552
  s_waitcnt lgkmcnt(0)
  v_pk_add_f32 v[92:93], v[92:93], v[94:95]
  v_add_f32 v92, v92, v93
  v_cvt_pk_bf16_f32 v50, v92, v92
  v_and_b32 v50, s60, v50
  v_add_f32 v50, v50, v42
  v_cvt_pk_bf16_f32 v50, v50, v50
  v_and_b32 v50, s60, v50
  s_cmp_eq_u32 s51, 0
  s_cbranch_scc1 L_SPARE
  s_cmp_lg_u32 s63, 0
  s_cbranch_scc1 L_sp_11
  s_mov_b64 s[6:7], exec
  s_mov_b64 exec, 0xff
  v_mov_b32 v2, s54
  s_mov_b32 s4, 24576
  buffer_store_dword v2, v56, s[40:43], s4 offen sc1
  s_mov_b64 exec, s[6:7]
L_sp_11:
  s_nop 1
  v_mov_b32_dpp v2, v50 quad_perm:[1,1,3,3] row_mask:0xf bank_mask:0xf
  v_cvt_pk_bf16_f32 v2, v50, v2
  v_cndmask_b32 v2, v2, v9, s[90:91]
  ds_bpermute_b32 v124, v38, v2 offset:0
  ds_bpermute_b32 v125, v38, v2 offset:8
  ds_bpermute_b32 v126, v38, v2 offset:16
  ds_bpermute_b32 v127, v38, v2 offset:24
  s_waitcnt lgkmcnt(0)
  v_perm_b32 v72, v124, v124, v64
  v_perm_b32 v73, v124, v124, v66
  v_perm_b32 v74, v124, v124, v68
  v_perm_b32 v75, v124, v124, v70
  s_waitcnt vmcnt(16)
  v_perm_b32 v76, v124, v124, v65
  v_perm_b32 v77, v124, v124, v67
  v_perm_b32 v78, v124, v124, v69
  v_perm_b32 v79, v124, v124, v71
  v_mfma_f32_16x16x32_bf16 v[80:83], v[72:75], a[0:3], 0
  v_mfma_f32_16x16x32_bf16 v[84:87], v[72:75], a[4:7], 0
  v_perm_b32 v72, v125, v125, v64
  v_perm_b32 v73, v125, v125, v66
  v_perm_b32 v74, v125, v125, v68
  v_perm_b32 v75, v125, v125, v70
  v_mfma_f32_16x16x32_bf16 v[80:83], v[76:79], a[8:11], v[80:83]
  v_mfma_f32_16x16x32_bf16 v[84:87], v[76:79], a[12:15], v[84:87]
  v_perm_b32 v76, v125, v125, v65
  v_perm_b32 v77, v125, v125, v67
  v_perm_b32 v78, v125, v125, v69
  v_perm_b32 v79, v125, v125, v71
  v_mfma_f32_16x16x32_bf16 v[80:83], v[72:75], a[16:19], v[80:83]
  v_mfma_f32_16x16x32_bf16 v[84:87], v[72:75], a[20:23], v[84:87]
  v_perm_b32 v72, v126, v126, v64
  v_perm_b32 v73, v126, v126, v66
  v_perm_b32 v74, v126, v126, v68
  v_perm_b32 v75, v126, v126, v70
  v_mfma_f32_16x16x32_bf16 v[80:83], v[76:79], a[24:27], v[80:83]
  v_mfma_f32_16x16x32_bf16 v[84:87], v[76:79], a[28:31], v[84:87]
  v_perm_b32 v76, v126, v126, v65
  v_perm_b32 v77, v126, v126, v67
  v_perm_b32 v78, v126, v126, v69
  v_perm_b32 v79, v126, v126, v71
  v_mfma_f32_16x16x32_bf16 v[80:83], v[72:75], a[32:35], v[80:83]
  v_mfma_f32_16x16x32_bf16 v[84:87], v[72:75], a[36:39], v[84:87]
  v_perm_b32 v72, v127, v127, v64
  v_perm_b32 v73, v127, v127, v66
  v_perm_b32 v74, v127, v127, v68
  v_perm_b32 v75, v127, v127, v70
  v_mfma_f32_16x16x32_bf16 v[80:83], v[76:79], a[40:43], v[80:83]
  v_mfma_f32_16x16x32_bf16 v[84:87], v[76:79], a[44:47], v[84:87]
  v_perm_b32 v76, v127, v127, v65
  v_perm_b32 v77, v127, v127, v67
  v_perm_b32 v78, v127, v127, v69
  v_perm_b32 v79, v127, v127, v71
  v_mfma_f32_16x16x32_bf16 v[80:83], v[72:75], a[48:51], v[80:83]
  v_mfma_f32_16x16x32_bf16 v[84:87], v[72:75], a[52:55], v[84:87]
  v_mfma_f32_16x16x32_bf16 v[80:83], v[76:79], a[56:59], v[80:83]
  v_mfma_f32_16x16x32_bf16 v[84:87], v[76:79], a[60:63], v[84:87]
  s_nop 7
  v_bfi_b32 v80, s56, v7, v80
  v_bfi_b32 v81, s56, v7, v81
  v_bfi_b32 v82, s56, v7, v82
  v_bfi_b32 v83, s56, v7, v83
  v_bfi_b32 v84, s56, v7, v84
  v_bfi_b32 v85, s56, v7, v85
  v_bfi_b32 v86, s56, v7, v86
  v_bfi_b32 v87, s56, v7, v87
  buffer_store_dwordx4 v[80:83], v43, s[40:43], 0 offen sc1
  buffer_store_dwordx4 v[84:87], v43, s[40:43], s47 offen sc1
  s_cmp_lg_u32 s3, 0
  s_cbranch_scc1 L_sw_12_ok
  s_mov_b32 s4, 24576
L_sw_12:
  buffer_load_dword v2, v57, s[40:43], s4 offen sc1
  s_waitcnt vmcnt(0)
  v_cmp_ne_u32 vcc, s54, v2
  s_cbranch_vccz L_sw_12_ok
  s_sub_u32 s61, s61, 1
  s_cbranch_scc1 L_END
  s_sleep 1
  s_branch L_sw_12
L_sw_12_ok:
  s_barrier
  buffer_load_dwordx4 v[120:123], v45, s[40:43], 0 offen sc1
  buffer_load_dwordx4 v[92:95], v44, s[40:43], 0 offen sc1
  buffer_load_dwordx4 v[96:99], v44, s[40:43], 0 offen offset:1024 sc1
  s_waitcnt vmcnt(0)
  v_bitop3_b32 v6, v120, v121, s57 bitop3:0x7e
  v_bitop3_b32 v3, v122, v123, s57 bitop3:0x7e
  v_or_b32 v6, v6, v3
  v_bitop3_b32 v2, v92, v93, s57 bitop3:0x7e
  v_bitop3_b32 v3, v94, v95, s57 bitop3:0x7e
  v_or3_b32 v6, v2, v3, v6
  v_bitop3_b32 v2, v96, v97, s57 bitop3:0x7e
  v_bitop3_b32 v3, v98, v99, s57 bitop3:0x7e
  v_or3_b32 v6, v2, v3, v6
  v_cmp_ne_u32_sdwa vcc, v6, v8 src0_sel:BYTE_0 src1_sel:DWORD
  s_cbranch_vccz L_ok_13
L_retry_14:
  s_sub_u32 s61, s61, 1
  s_cbranch_scc1 L_END
  s_sleep 3
  buffer_load_dwordx4 v[120:123], v45, s[40:43], 0 offen sc1
  buffer_load_dwordx4 v[92:95], v44, s[40:43], 0 offen sc1
  buffer_load_dwordx4 v[96:99], v44, s[40:43], 0 offen offset:1024 sc1
  s_waitcnt vmcnt(0)
  v_bitop3_b32 v6, v120, v121, s57 bitop3:0x7e
  v_bitop3_b32 v3, v122, v123, s57 bitop3:0x7e
  v_or_b32 v6, v6, v3
  v_bitop3_b32 v2, v92, v93, s57 bitop3:0x7e
  v_bitop3_b32 v3, v94, v95, s57 bitop3:0x7e
  v_or3_b32 v6, v2, v3, v6
  v_bitop3_b32 v2, v96, v97, s57 bitop3:0x7e
  v_bitop3_b32 v3, v98, v99, s57 bitop3:0x7e
  v_or3_b32 v6, v2, v3, v6
  v_cmp_ne_u32_sdwa vcc, v6, v8 src0_sel:BYTE_0 src1_sel:DWORD
  s_cbranch_vccnz L_retry_14
  s_branch L_ok_13
L_ok_13:
  v_pk_add_f32 v[92:93], v[92:93], v[96:97]
  v_pk_add_f32 v[94:95], v[94:95], v[98:99]
  s_nop 1
  v_permlane32_swap_b32 v92, v94
  v_permlane32_swap_b32 v93, v95
  v_add_f32 v92, v92, v94
  v_add_f32 v93, v93, v95
  s_nop 1
  v_permlane16_swap_b32 v92, v93
  v_add_f32 v92, v92, v93
  ds_write_b32 v46, v92 offset:16384
  s_nop 0
  v_add_f32_dpp v120, v120, v120 quad_perm:[1,0,3,2] row_mask:0xf bank_mask:0xf
  v_add_f32_dpp v121, v121, v121 quad_perm:[1,0,3,2] row_mask:0xf bank_mask:0xf
  s_nop 0
  v_add_f32_dpp v120, v120, v120 quad_perm:[2,3,0,1] row_mask:0xf bank_mask:0xf
  v_add_f32_dpp v121, v121, v121 quad_perm:[2,3,0,1] row_mask:0xf bank_mask:0xf
  s_nop 0
  v_add_f32_dpp v120, v120, v120 row_half_mirror row_mask:0xf bank_mask:0xf
  v_add_f32_dpp v121, v121, v121 row_half_mirror row_mask:0xf bank_mask:0xf
  s_nop 0
  v_add_f32_dpp v120, v120, v120 row_mirror row_mask:0xf bank_mask:0xf
  v_add_f32_dpp v121, v121, v121 row_mirror row_mask:0xf bank_mask:0xf
  v_mov_b32 v2, v120
  v_mov_b32 v3, v121
  s_nop 0
  v_permlane16_swap_b32 v120, v2
  v_permlane16_swap_b32 v121, v3
  v_add_f32 v120, v120, v2
  v_add_f32 v121, v121, v3
  v_mul_f32 v51, 0x3a800000, v120
  v_mul_f32 v52, 0x3a800000, v121
  v_fma_f32 v52, -v51, v51, v52
  v_max_f32 v52, 0, v52
  v_cvt_pk_bf16_f32 v2, v51, v52
  v_lshlrev_b32 v51, 16, v2
  v_and_b32 v52, s60, v2
  v_add_f32 v52, 0x3727c5ac, v52
  v_cvt_pk_bf16_f32 v52, v52, v52
  v_and_b32 v52, s60, v52
  v_sqrt_f32 v52, v52
  s_waitcnt lgkmcnt(0)
  s_barrier
  ds_read_b128 v[92:95], v10 offset:16384
  v_cvt_pk_bf16_f32 v52, v52, v52
  v_and_b32 v52, s60, v52
  v_rcp_f32 v60, v52
  s_waitcnt lgkmcnt(0)
  v_pk_add_f32 v[92:93], v[92:93], v[94:95]
  v_add_f32 v50, v92, v93
  v_mov_b32 v61, v50
  s_nop 1
  v_permlane16_swap_b32 v50, v61
  v_fma_f32 v50, -v51, v61, v50
  v_mul_f32 v2, v50, v60
  v_fma_f32 v3, -v2, v52, v50
  v_fma_f32 v50, v3, v60, v2
  v_cvt_pk_bf16_f32 v50, v50, v50
  v_and_b32 v50, s60, v50
  v_mov_b32 v61, v50
  s_nop 1
  v_permlane32_swap_b32 v50, v61
  v_max_f32 v50, 0, v50
  v_mul_f32 v50, v50, v61
  s_cmp_lg_u32 s63, 0
  s_cbranch_scc1 L_sp_15
  s_mov_b64 s[6:7], exec
  s_mov_b64 exec, 0xff
  v_mov_b32 v2, s54
  s_mov_b32 s4, 32768
  buffer_store_dword v2, v56, s[40:43], s4 offen sc1
  s_mov_b64 exec, s[6:7]
L_sp_15:
  s_nop 1
  v_mov_b32_dpp v2, v50 quad_perm:[1,1,3,3] row_mask:0xf bank_mask:0xf
  v_cvt_pk_bf16_f32 v2, v50, v2
  ds_bpermute_b32 v124, v39, v2 offset:0
  ds_bpermute_b32 v125, v39, v2 offset:8
  s_waitcnt lgkmcnt(0)
  v_perm_b32 v72, v124, v124, v64
  v_perm_b32 v73, v124, v124, v66
  v_perm_b32 v74, v124, v124, v68
  v_perm_b32 v75, v124, v124, v70
  s_waitcnt vmcnt(10)
  v_perm_b32 v76, v124, v124, v65
  v_perm_b32 v77, v124, v124, v67
  v_perm_b32 v78, v124, v124, v69
  v_perm_b32 v79, v124, v124, v71
  v_mfma_f32_16x16x32_bf16 v[80:83], v[72:75], v[128:131], 0
  v_mfma_f32_16x16x32_bf16 v[84:87], v[72:75], v[132:135], 0
  v_perm_b32 v72, v125, v125, v64
  v_perm_b32 v73, v125, v125, v66
  v_perm_b32 v74, v125, v125, v68
  v_perm_b32 v75, v125, v125, v70
  v_mfma_f32_16x16x32_bf16 v[80:83], v[76:79], v[136:139], v[80:83]
  v_mfma_f32_16x16x32_bf16 v[84:87], v[76:79], v[140:143], v[84:87]
  v_perm_b32 v76, v125, v125, v65
  v_perm_b32 v77, v125, v125, v67
  v_perm_b32 v78, v125, v125, v69
  v_perm_b32 v79, v125, v125, v71
  v_mfma_f32_16x16x32_bf16 v[80:83], v[72:75], v[144:147], v[80:83]
  v_mfma_f32_16x16x32_bf16 v[84:87], v[72:75], v[148:151], v[84:87]
  v_mfma_f32_16x16x32_bf16 v[80:83], v[76:79], v[152:155], v[80:83]
  v_mfma_f32_16x16x32_bf16 v[84:87], v[76:79], v[156:159], v[84:87]
  s_nop 7
  v_bfi_b32 v80, s56, v7, v80
  v_bfi_b32 v81, s56, v7, v81
  v_bfi_b32 v82, s56, v7, v82
  v_bfi_b32 v83, s56, v7, v83
  v_bfi_b32 v84, s56, v7, v84
  v_bfi_b32 v85, s56, v7, v85
  v_bfi_b32 v86, s56, v7, v86
  v_bfi_b32 v87, s56, v7, v87
  s_mov_b32 exec_hi, 0
  buffer_store_dwordx4 v[80:83], v47, s[40:43], 0 offen sc1
  buffer_store_dwordx4 v[84:87], v47, s[40:43], s53 offen sc1
  s_endpgm
L_SPARE:
  v_mov_b32 v54, v50
  v_mov_b32 v120, v50
  v_mul_f32 v121, v50, v50
  s_nop 0
  v_add_f32_dpp v120, v120, v120 quad_perm:[1,0,3,2] row_mask:0xf bank_mask:0xf
  v_add_f32_dpp v121, v121, v121 quad_perm:[1,0,3,2] row_mask:0xf bank_mask:0xf
  s_nop 0
  v_add_f32_dpp v120, v120, v120 quad_perm:[2,3,0,1] row_mask:0xf bank_mask:0xf
  v_add_f32_dpp v121, v121, v121 quad_perm:[2,3,0,1] row_mask:0xf bank_mask:0xf
  s_nop 0
  v_add_f32_dpp v120, v120, v120 row_half_mirror row_mask:0xf bank_mask:0xf
  v_add_f32_dpp v121, v121, v121 row_half_mirror row_mask:0xf bank_mask:0xf
  s_nop 0
  v_add_f32_dpp v120, v120, v120 row_mirror row_mask:0xf bank_mask:0xf
  v_add_f32_dpp v121, v121, v121 row_mirror row_mask:0xf bank_mask:0xf
  v_mov_b32 v2, v120
  v_mov_b32 v3, v121
  s_nop 0
  v_permlane16_swap_b32 v120, v2
  v_permlane16_swap_b32 v121, v3
  v_add_f32 v120, v120, v2
  v_add_f32 v121, v121, v3
  v_mov_b32 v122, v120
  v_mov_b32 v123, v121
  v_bfi_b32 v120, s56, v7, v120
  v_bfi_b32 v121, s56, v7, v121
  v_bfi_b32 v122, s56, v7, v122
  v_bfi_b32 v123, s56, v7, v123
  s_cmp_lg_u32 s3, 0
  s_cbranch_scc1 L_stskip_16
  s_lshl_b32 s4, s101, 4
  s_add_u32 s4, s4, 163840
  s_mov_b64 exec, 1
  buffer_store_dwordx4 v[120:123], v8, s[40:43], s4 offen sc1
  s_cmp_lg_u32 s101, 0
  s_cbranch_scc1 L_stskip_16_e
  v_mov_b32 v3, s54
  buffer_store_dword v3, v8, s[40:43], 0 offen sc1
L_stskip_16_e:
  s_mov_b64 exec, -1
L_stskip_16:
  s_waitcnt vmcnt(0)
  s_cmp_lg_u32 s3, 0
  s_cbranch_scc1 L_sw_17_ok
  s_mov_b32 s4, 32768
L_sw_17:
  buffer_load_dword v2, v57, s[40:43], s4 offen sc1
  s_waitcnt vmcnt(0)
  v_cmp_ne_u32 vcc, s54, v2
  s_cbranch_vccz L_sw_17_ok
  s_sub_u32 s61, s61, 1
  s_cbranch_scc1 L_END
  s_sleep 1
  s_branch L_sw_17
L_sw_17_ok:
  s_barrier
  s_sleep 6
  buffer_load_dwordx4 v[92:95], v48, s[40:43], 0 offen offset:0 sc1
  buffer_load_dwordx4 v[96:99], v48, s[40:43], 0 offen offset:1024 sc1
  buffer_load_dwordx4 v[100:103], v48, s[40:43], 0 offen offset:2048 sc1
  buffer_load_dwordx4 v[104:107], v48, s[40:43], 0 offen offset:3072 sc1
  buffer_load_dwordx4 v[108:111], v48, s[40:43], s52 offen offset:0 sc1
  buffer_load_dwordx4 v[112:115], v48, s[40:43], s52 offen offset:1024 sc1
  buffer_load_dwordx4 v[116:119], v48, s[40:43], s52 offen offset:2048 sc1
  s_waitcnt vmcnt(0)
  v_bitop3_b32 v6, v92, v93, s57 bitop3:0x7e
  v_bitop3_b32 v3, v94, v95, s57 bitop3:0x7e
  v_or_b32 v6, v6, v3
  v_bitop3_b32 v2, v96, v97, s57 bitop3:0x7e
  v_bitop3_b32 v3, v98, v99, s57 bitop3:0x7e
  v_or3_b32 v6, v2, v3, v6
  v_bitop3_b32 v2, v100, v101, s57 bitop3:0x7e
  v_bitop3_b32 v3, v102, v103, s57 bitop3:0x7e
  v_or3_b32 v6, v2, v3, v6
  v_bitop3_b32 v2, v104, v105, s57 bitop3:0x7e
  v_bitop3_b32 v3, v106, v107, s57 bitop3:0x7e
  v_or3_b32 v6, v2, v3, v6
  v_bitop3_b32 v2, v108, v109, s57 bitop3:0x7e
  v_bitop3_b32 v3, v110, v111, s57 bitop3:0x7e
  v_or3_b32 v6, v2, v3, v6
  v_bitop3_b32 v2, v112, v113, s57 bitop3:0x7e
  v_bitop3_b32 v3, v114, v115, s57 bitop3:0x7e
  v_or3_b32 v6, v2, v3, v6
  v_bitop3_b32 v2, v116, v117, s57 bitop3:0x7e
  v_bitop3_b32 v3, v118, v119, s57 bitop3:0x7e
  v_or3_b32 v6, v2, v3, v6
  v_cmp_ne_u32_sdwa vcc, v6, v8 src0_sel:BYTE_0 src1_sel:DWORD
  s_cbranch_vccz L_ok_18
L_retry_19:
  s_sub_u32 s61, s61, 1
  s_cbranch_scc1 L_END
  s_sleep 3
  buffer_load_dwordx4 v[92:95], v48, s[40:43], 0 offen offset:0 sc1
  buffer_load_dwordx4 v[96:99], v48, s[40:43], 0 offen offset:1024 sc1
  buffer_load_dwordx4 v[100:103], v48, s[40:43], 0 offen offset:2048 sc1
  buffer_load_dwordx4 v[104:107], v48, s[40:43], 0 offen offset:3072 sc1
  buffer_load_dwordx4 v[108:111], v48, s[40:43], s52 offen offset:0 sc1
  buffer_load_dwordx4 v[112:115], v48, s[40:43], s52 offen offset:1024 sc1
  buffer_load_dwordx4 v[116:119], v48, s[40:43], s52 offen offset:2048 sc1
  s_waitcnt vmcnt(0)
  v_bitop3_b32 v6, v92, v93, s57 bitop3:0x7e
  v_bitop3_b32 v3, v94, v95, s57 bitop3:0x7e
  v_or_b32 v6, v6, v3
  v_bitop3_b32 v2, v96, v97, s57 bitop3:0x7e
  v_bitop3_b32 v3, v98, v99, s57 bitop3:0x7e
  v_or3_b32 v6, v2, v3, v6
  v_bitop3_b32 v2, v100, v101, s57 bitop3:0x7e
  v_bitop3_b32 v3, v102, v103, s57 bitop3:0x7e
  v_or3_b32 v6, v2, v3, v6
  v_bitop3_b32 v2, v104, v105, s57 bitop3:0x7e
  v_bitop3_b32 v3, v106, v107, s57 bitop3:0x7e
  v_or3_b32 v6, v2, v3, v6
  v_bitop3_b32 v2, v108, v109, s57 bitop3:0x7e
  v_bitop3_b32 v3, v110, v111, s57 bitop3:0x7e
  v_or3_b32 v6, v2, v3, v6
  v_bitop3_b32 v2, v112, v113, s57 bitop3:0x7e
  v_bitop3_b32 v3, v114, v115, s57 bitop3:0x7e
  v_or3_b32 v6, v2, v3, v6
  v_bitop3_b32 v2, v116, v117, s57 bitop3:0x7e
  v_bitop3_b32 v3, v118, v119, s57 bitop3:0x7e
  v_or3_b32 v6, v2, v3, v6
  v_cmp_ne_u32_sdwa vcc, v6, v8 src0_sel:BYTE_0 src1_sel:DWORD
  s_cbranch_vccnz L_retry_19
  s_branch L_ok_18
L_ok_18:
  v_pk_add_f32 v[92:93], v[92:93], v[96:97]
  v_pk_add_f32 v[94:95], v[94:95], v[98:99]
  v_pk_add_f32 v[100:101], v[100:101], v[104:105]
  v_pk_add_f32 v[102:103], v[102:103], v[106:107]
  v_pk_add_f32 v[108:109], v[108:109], v[112:113]
  v_pk_add_f32 v[110:111], v[110:111], v[114:115]
  v_pk_add_f32 v[92:93], v[92:93], v[100:101]
  v_pk_add_f32 v[94:95], v[94:95], v[102:103]
  v_pk_add_f32 v[108:109], v[108:109], v[116:117]
  v_pk_add_f32 v[110:111], v[110:111], v[118:119]
  v_pk_add_f32 v[92:93], v[92:93], v[108:109]
  v_pk_add_f32 v[94:95], v[94:95], v[110:111]
  s_nop 1
  v_permlane32_swap_b32 v92, v94
  v_permlane32_swap_b32 v93, v95
  v_add_f32 v92, v92, v94
  v_add_f32 v93, v93, v95
  s_nop 1
  v_permlane16_swap_b32 v92, v93
  v_add_f32 v92, v92, v93
  s_nop 1
  v_add_f32_dpp v92, v92, v92 row_ror:8 row_mask:0xf bank_mask:0xf
  ds_write_b32 v35, v92 offset:16384
  s_waitcnt lgkmcnt(0)
  s_barrier
  ds_read_b128 v[92:95], v36 offset:16384
  s_waitcnt lgkmcnt(0)
  v_pk_add_f32 v[92:93], v[92:93], v[94:95]
  v_add_f32 v92, v92, v93
  v_cvt_pk_bf16_f32 v50, v92, v92
  v_and_b32 v50, s60, v50
  v_add_f32 v50, v50, v54
  s_nop 1
  v_mov_b32_dpp v2, v50 quad_perm:[1,1,3,3] row_mask:0xf bank_mask:0xf
  v_cvt_pk_bf16_f32 v2, v50, v2
  s_cmp_lg_u32 s3, 0
  s_cbranch_scc1 L_FIN
  s_mov_b32 exec_lo, 0x55555555
  s_mov_b32 exec_hi, 0
  buffer_store_dword v2, v49, s[36:39], 0 offen
L_FIN:
L_END:
  s_endpgm
L_CODE_END:
.section .rodata,"a"
.p2align 6
.amdhsa_kernel sequential_preLN__sliding_block_cached__glu_gated_reglu__decode_kernel
  .amdhsa_next_free_vgpr 288
  .amdhsa_next_free_sgpr 102
  .amdhsa_accum_offset 192
  .amdhsa_group_segment_fixed_size 0
  .amdhsa_kernarg_size 96
  .amdhsa_user_sgpr_count 2
  .amdhsa_user_sgpr_kernarg_segment_ptr 1
  .amdhsa_system_sgpr_workgroup_id_x 1
.end_amdhsa_kernel
```
